```python
import torch

def _softmax(x, axis=-1):
    return torch.softmax(x, dim=axis)
def _gelu(x):
    return torch.nn.functional.gelu(x, approximate="tanh")
def _silu(x):
    return torch.nn.functional.silu(x)
def _sigmoid(x):
    return torch.sigmoid(x)
def _layernorm(x, axis=-1, eps=1e-5):
    m = x.mean(dim=axis, keepdim=True)
    v = x.var(dim=axis, keepdim=True, unbiased=False)
    return (x - m) / torch.sqrt(v + eps)
def _scatter_add(tgt, idx, src, axis=0):
    return tgt.clone().index_add_(axis, idx, src)
def _segment_sum(src, seg, n):
    out = torch.zeros((n,) + src.shape[1:], dtype=src.dtype)
    return out.index_add_(0, seg, src)
def _pad(x, pw):
    flat = tuple(v for pair in reversed(pw) for v in pair)
    return torch.nn.functional.pad(x, flat)

kernel_name = 'standalone__low_rank_proj_linformer__prompt'

def setup_inputs():

    _w = (lambda a: (lambda t: t.to(torch.bfloat16) if t.is_floating_point() else t)(torch.as_tensor(a)))
    B, H, Sq, Skv, Dh, R = 1, 32, 2048, 2048, 128, 16
    return {
        "q": _w((lambda *s: torch.randn(*s, dtype=torch.bfloat16) * 0.8)(B, H, Sq, Dh)),
        "k": _w((lambda *s: torch.randn(*s, dtype=torch.bfloat16) * 0.8)(B, H, Skv, Dh)),
        "v": _w((lambda *s: torch.randn(*s, dtype=torch.bfloat16) * 0.05)(B, H, Skv, Dh)),
        "e_proj": _w((lambda *s: torch.randn(*s, dtype=torch.bfloat16) * 0.8)(R, Skv) * (Skv ** -0.5)),
        "f_proj": _w((lambda *s: torch.randn(*s, dtype=torch.bfloat16) * 0.05)(R, Skv) * (Skv ** -0.5)),
    }

def reference(q, k, v, e_proj, f_proj):
    B, H, Sq, Dh = q.shape
    kp = torch.einsum("rn,bhnd->bhrd", e_proj, k)
    vp = torch.einsum("rn,bhnd->bhrd", f_proj, v)
    scores = torch.einsum("bhqd,bhrd->bhqr", q, kp) * (Dh ** -0.5)
    p = _softmax(scores, axis=-1)
    o = torch.einsum("bhqr,bhrd->bhqd", p, vp)
    return o
```

```asm
; @launch grid=(256,1,1) block=(512,1,1) lds=155968
.amdgcn_target "amdgcn-amd-amdhsa--gfx950"
.text
.globl standalone__low_rank_proj_linformer__prompt_kernel
.p2align 8
.type standalone__low_rank_proj_linformer__prompt_kernel,@function
standalone__low_rank_proj_linformer__prompt_kernel:
s_load_dwordx8 s[4:11], s[0:1], 0
s_load_dwordx8 s[40:47], s[0:1], 32
s_cmp_ge_u32 s2, 256
s_cbranch_scc1 L_end
v_lshrrev_b32 v1, 6, v0
v_and_b32 v2, 63, v0
v_and_b32 v3, 15, v0
v_readfirstlane_b32 s3, v1
v_lshrrev_b32 v4, 4, v2
s_and_b32 s48, s2, 7
s_lshr_b32 s49, s2, 6
s_lshl_b32 s49, s49, 3
s_add_u32 s48, s48, s49
s_lshr_b32 s49, s2, 3
s_and_b32 s49, s49, 7
s_lshr_b32 s50, s49, 1
s_lshl_b32 s51, s50, 3
s_mov_b32 s12, 0
s_add_u32 s12, s12, s3
s_and_b32 s12, s12, 7
s_add_u32 s51, s51, s12
s_lshl_b32 s52, s51, 7
s_lshl_b32 s53, s51, 14
s_lshl_b32 s54, s48, 19
s_add_u32 s53, s53, s54
s_add_u32 s55, s53, 0x2000
s_lshl_b32 s57, s48, 16
s_lshl_b32 s58, s3, 10
s_add_u32 s57, s57, s58
s_lshl_b32 s58, s49, 13
s_add_u32 s58, s58, s57
v_lshlrev_b32 v5, 11, v4
v_lshl_add_u32 v5, v3, 4, v5
v_lshlrev_b32 v6, 12, v3
v_lshl_add_u32 v6, v4, 4, v6
v_mov_b32 v8, 0
s_mov_b32 s22, 0x1000000
s_mov_b32 s23, 0x20000
s_mov_b32 s26, 0x10000
s_mov_b32 s27, 0x20000
s_mov_b32 s34, 0x10000000
s_mov_b32 s35, 0x20000
s_and_b32 s59, s49, 1
s_cmp_eq_u32 s59, 0
s_waitcnt lgkmcnt(0)
s_cselect_b32 s20, s6, s8
s_cselect_b32 s21, s7, s9
s_cselect_b32 s24, s10, s40
s_cselect_b32 s25, s11, s41
s_mov_b32 s32, s46
s_mov_b32 s33, s47
s_cmp_lg_u32 s3, 0
s_cbranch_scc1 L_nows
buffer_load_dwordx4 v[12:15], v8, s[32:35], s58 offen sc1
L_nows:
v_lshlrev_b32 v7, 4, v2
s_lshl_b32 s52, s3, 13
s_lshl_b32 s13, s50, 10
s_add_u32 s52, s52, s13
s_mul_i32 s13, s3, 2080
s_add_u32 m0, s13, 139328
s_add_u32 s14, s52, 4096
buffer_load_dwordx4 v7, s[24:27], s52 offen lds
s_add_u32 m0, s13, 140368
s_nop 0
buffer_load_dwordx4 v7, s[24:27], s14 offen lds
s_barrier
buffer_load_dwordx4 v[24:27], v5, s[20:23], s53 offen offset:0 nt
buffer_load_dwordx4 v[28:31], v5, s[20:23], s53 offen offset:256 nt
buffer_load_dwordx4 v[32:35], v5, s[20:23], s53 offen offset:512 nt
buffer_load_dwordx4 v[36:39], v5, s[20:23], s53 offen offset:768 nt
buffer_load_dwordx4 v[40:43], v5, s[20:23], s53 offen offset:1024 nt
buffer_load_dwordx4 v[44:47], v5, s[20:23], s53 offen offset:1280 nt
buffer_load_dwordx4 v[48:51], v5, s[20:23], s53 offen offset:1536 nt
buffer_load_dwordx4 v[52:55], v5, s[20:23], s53 offen offset:1792 nt
buffer_load_dwordx4 v[56:59], v5, s[20:23], s55 offen offset:0 nt
buffer_load_dwordx4 v[60:63], v5, s[20:23], s55 offen offset:256 nt
buffer_load_dwordx4 v[64:67], v5, s[20:23], s55 offen offset:512 nt
buffer_load_dwordx4 v[68:71], v5, s[20:23], s55 offen offset:768 nt
buffer_load_dwordx4 v[72:75], v5, s[20:23], s55 offen offset:1024 nt
buffer_load_dwordx4 v[76:79], v5, s[20:23], s55 offen offset:1280 nt
buffer_load_dwordx4 v[80:83], v5, s[20:23], s55 offen offset:1536 nt
buffer_load_dwordx4 v[84:87], v5, s[20:23], s55 offen offset:1792 nt
s_mov_b32 s16, s4
s_mov_b32 s17, s5
s_mov_b32 s18, 0x1000000
s_mov_b32 s19, 0x20000
s_mov_b32 s28, s42
s_mov_b32 s29, s43
s_mov_b32 s30, 0x1000000
s_mov_b32 s31, 0x20000
s_mov_b32 s36, s44
s_mov_b32 s37, s45
s_mov_b32 s38, 256
s_mov_b32 s39, 0x20000
s_lshl_b32 s56, s49, 3
s_add_u32 s56, s56, s12
s_lshl_b32 s56, s56, 13
s_add_u32 s56, s56, s54
s_getreg_b32 s59, hwreg(HW_REG_XCC_ID, 0, 4)
s_add_u32 s59, s59, 1
s_and_b32 s59, s59, 0xff
s_lshl_b32 s70, s3, 13
v_lshlrev_b32 v7, 4, v2
v_lshlrev_b32 v9, 2, v4
v_xor_b32 v9, v9, v3
v_lshlrev_b32 v10, 11, v4
s_lshl_b32 s60, s3, 1
s_add_u32 s60, s60, 131072
v_lshlrev_b32 v1, 10, v4
v_add_u32 v1, s60, v1
v_xor_b32 v11, 0, v9
v_lshl_add_u32 v88, v11, 4, v10
v_lshl_add_u32 v164, v11, 4, v1
v_xor_b32 v11, 1, v9
v_lshl_add_u32 v89, v11, 4, v10
v_lshl_add_u32 v165, v11, 4, v1
v_xor_b32 v11, 2, v9
v_lshl_add_u32 v90, v11, 4, v10
v_lshl_add_u32 v166, v11, 4, v1
v_xor_b32 v11, 3, v9
v_lshl_add_u32 v91, v11, 4, v10
v_lshl_add_u32 v167, v11, 4, v1
s_add_u32 s60, s70, 65536
v_add_u32 v160, s60, v7
s_lshl_b32 s60, s3, 10
s_add_u32 s60, s60, 65536
v_add_u32 v161, s60, v7
v_mov_b32 v162, 139264
s_lshr_b32 s60, s3, 1
s_lshl_b32 s60, s60, 10
s_and_b32 s61, s3, 1
s_lshl_b32 s61, s61, 3
s_add_u32 s60, s60, s61
s_add_u32 s60, s60, 135168
v_add_u32 v163, s60, v7
v_xor_b32 v9, v4, v3
v_lshlrev_b32 v9, 4, v9
v_lshl_add_u32 v10, v3, 8, v9
v_add_u32 v10, 131072, v10
v_and_b32 v11, 3, v3
v_lshl_add_u32 v9, v11, 10, v9
v_lshrrev_b32 v11, 2, v3
v_lshl_add_u32 v9, v11, 8, v9
v_add_u32 v9, s70, v9
v_add_u32 v176, 135168, v7
v_mov_b32 v210, 0x3e0293ee
v_mov_b32 v211, 0x3e0293ee
v_xor_b32 v168, 0, v10
v_xor_b32 v172, 0, v9
v_xor_b32 v169, 64, v10
v_xor_b32 v173, 64, v9
v_xor_b32 v170, 128, v10
v_xor_b32 v174, 128, v9
v_xor_b32 v171, 192, v10
v_xor_b32 v175, 192, v9
s_xor_b32 s4, s58, 0
s_xor_b32 s5, s58, 8192
s_xor_b32 s6, s58, 16384
s_xor_b32 s7, s58, 24576
s_xor_b32 s8, s58, 32768
s_xor_b32 s9, s58, 40960
s_xor_b32 s10, s58, 49152
s_xor_b32 s11, s58, 57344
s_mov_b32 s61, 0x05040100
s_mov_b32 s62, 0x07060302
s_movk_i32 s63, 0xfff
s_mov_b32 s71, 0x3e0293ee
s_lshl_b32 s13, s12, 7
s_add_u32 s13, s13, 139328
v_mul_u32_u24 v6, 1040, v3
v_lshl_add_u32 v6, v4, 4, v6
v_add_u32 v6, s13, v6
s_waitcnt vmcnt(16)
s_cmp_lg_u32 s3, 0
s_cbranch_scc1 L_nononce
s_waitcnt vmcnt(18)
v_add_u32 v12, 0x1a7, v12
v_add_u32 v13, 0xc9, v13
v_add_u32 v14, 0x71d, v14
v_and_b32 v12, 0x3ff, v12
v_and_b32 v13, 0x1ff, v13
v_and_b32 v14, 0xfff, v14
v_lshl_or_b32 v12, v13, 10, v12
v_lshl_or_b32 v12, v14, 19, v12
v_or_b32 v12, 0x80000000, v12
v_mov_b32 v13, 0
v_mov_b32 v92, v12
s_lshl_b32 s60, s48, 2
s_mov_b64 exec, 1
buffer_atomic_cmpswap v[12:13], v8, s[36:39], s60 offen offset:128 sc0 sc1
s_mov_b64 exec, -1
L_nononce:

s_barrier
ds_read_b128 v[16:19], v6
ds_read_b128 v[20:23], v6 offset:64
s_add_u32 m0, s70, 0
s_nop 0
buffer_load_dwordx4 v88, s[16:19], s56 offen offset:0 nt lds
s_add_u32 m0, s70, 768
s_nop 0
buffer_load_dwordx4 v89, s[16:19], s56 offen offset:256 nt lds
s_add_u32 m0, s70, 1536
s_nop 0
buffer_load_dwordx4 v90, s[16:19], s56 offen offset:512 nt lds
s_add_u32 m0, s70, 2304
s_nop 0
buffer_load_dwordx4 v91, s[16:19], s56 offen offset:768 nt lds
s_waitcnt lgkmcnt(0)
s_waitcnt vmcnt(12)
v_perm_b32 v128, v28, v24, s61
v_perm_b32 v129, v36, v32, s61
v_perm_b32 v130, v44, v40, s61
v_perm_b32 v131, v52, v48, s61
v_perm_b32 v132, v28, v24, s62
v_perm_b32 v133, v36, v32, s62
v_perm_b32 v134, v44, v40, s62
v_perm_b32 v135, v52, v48, s62
v_mfma_f32_16x16x32_bf16 v[96:99], v[16:19], v[128:131], 0
v_perm_b32 v136, v29, v25, s61
v_perm_b32 v137, v37, v33, s61
v_perm_b32 v138, v45, v41, s61
v_perm_b32 v139, v53, v49, s61
v_mfma_f32_16x16x32_bf16 v[100:103], v[16:19], v[132:135], 0
v_perm_b32 v140, v29, v25, s62
v_perm_b32 v141, v37, v33, s62
v_perm_b32 v142, v45, v41, s62
v_perm_b32 v143, v53, v49, s62
v_mfma_f32_16x16x32_bf16 v[104:107], v[16:19], v[136:139], 0
v_perm_b32 v128, v30, v26, s61
v_perm_b32 v129, v38, v34, s61
v_perm_b32 v130, v46, v42, s61
v_perm_b32 v131, v54, v50, s61
v_mfma_f32_16x16x32_bf16 v[108:111], v[16:19], v[140:143], 0
v_perm_b32 v132, v30, v26, s62
v_perm_b32 v133, v38, v34, s62
v_perm_b32 v134, v46, v42, s62
v_perm_b32 v135, v54, v50, s62
v_mfma_f32_16x16x32_bf16 v[112:115], v[16:19], v[128:131], 0
v_perm_b32 v136, v31, v27, s61
v_perm_b32 v137, v39, v35, s61
v_perm_b32 v138, v47, v43, s61
v_perm_b32 v139, v55, v51, s61
v_mfma_f32_16x16x32_bf16 v[116:119], v[16:19], v[132:135], 0
v_perm_b32 v140, v31, v27, s62
v_perm_b32 v141, v39, v35, s62
v_perm_b32 v142, v47, v43, s62
v_perm_b32 v143, v55, v51, s62
v_mfma_f32_16x16x32_bf16 v[120:123], v[16:19], v[136:139], 0
s_nop 1
v_mfma_f32_16x16x32_bf16 v[124:127], v[16:19], v[140:143], 0
s_waitcnt vmcnt(4)
v_perm_b32 v128, v60, v56, s61
v_perm_b32 v129, v68, v64, s61
v_perm_b32 v130, v76, v72, s61
v_perm_b32 v131, v84, v80, s61
v_perm_b32 v132, v60, v56, s62
v_perm_b32 v133, v68, v64, s62
v_perm_b32 v134, v76, v72, s62
v_perm_b32 v135, v84, v80, s62
v_mfma_f32_16x16x32_bf16 v[96:99], v[20:23], v[128:131], v[96:99]
v_perm_b32 v136, v61, v57, s61
v_perm_b32 v137, v69, v65, s61
v_perm_b32 v138, v77, v73, s61
v_perm_b32 v139, v85, v81, s61
v_mfma_f32_16x16x32_bf16 v[100:103], v[20:23], v[132:135], v[100:103]
v_perm_b32 v140, v61, v57, s62
v_perm_b32 v141, v69, v65, s62
v_perm_b32 v142, v77, v73, s62
v_perm_b32 v143, v85, v81, s62
v_mfma_f32_16x16x32_bf16 v[104:107], v[20:23], v[136:139], v[104:107]
ds_write_b128 v160, v[96:99] offset:0
v_perm_b32 v128, v62, v58, s61
v_perm_b32 v129, v70, v66, s61
v_perm_b32 v130, v78, v74, s61
v_perm_b32 v131, v86, v82, s61
v_mfma_f32_16x16x32_bf16 v[108:111], v[20:23], v[140:143], v[108:111]
ds_write_b128 v160, v[100:103] offset:1024
v_perm_b32 v132, v62, v58, s62
v_perm_b32 v133, v70, v66, s62
v_perm_b32 v134, v78, v74, s62
v_perm_b32 v135, v86, v82, s62
v_mfma_f32_16x16x32_bf16 v[112:115], v[20:23], v[128:131], v[112:115]
ds_write_b128 v160, v[104:107] offset:2048
v_perm_b32 v136, v63, v59, s61
v_perm_b32 v137, v71, v67, s61
v_perm_b32 v138, v79, v75, s61
v_perm_b32 v139, v87, v83, s61
v_mfma_f32_16x16x32_bf16 v[116:119], v[20:23], v[132:135], v[116:119]
ds_write_b128 v160, v[108:111] offset:3072
v_perm_b32 v140, v63, v59, s62
v_perm_b32 v141, v71, v67, s62
v_perm_b32 v142, v79, v75, s62
v_perm_b32 v143, v87, v83, s62
v_mfma_f32_16x16x32_bf16 v[120:123], v[20:23], v[136:139], v[120:123]
ds_write_b128 v160, v[112:115] offset:4096
s_nop 1
v_mfma_f32_16x16x32_bf16 v[124:127], v[20:23], v[140:143], v[124:127]
s_cmp_lg_u32 s3, 0
s_cbranch_scc1 L_non2
v_cmp_eq_u32 vcc, 0, v12
s_nop 1
v_cndmask_b32 v12, v12, v92, vcc
s_mov_b64 exec, 1
ds_write_b32 v162, v12
s_mov_b64 exec, -1
L_non2:
s_nop 2
ds_write_b128 v160, v[116:119] offset:5120
ds_write_b128 v160, v[120:123] offset:6144
s_nop 1
ds_write_b128 v160, v[124:127] offset:7168
s_waitcnt lgkmcnt(0)
s_barrier
ds_read_b32 v12, v162
ds_read_b128 v[28:31], v161 offset:0
ds_read_b128 v[32:35], v161 offset:8192
ds_read_b128 v[36:39], v161 offset:16384
ds_read_b128 v[40:43], v161 offset:24576
ds_read_b128 v[44:47], v161 offset:32768
ds_read_b128 v[48:51], v161 offset:40960
ds_read_b128 v[52:55], v161 offset:49152
ds_read_b128 v[56:59], v161 offset:57344
s_waitcnt lgkmcnt(6)
v_and_b32 v16, 0xfff, v12
v_bfe_u32 v17, v12, 10, 12
v_bfe_u32 v18, v12, 19, 12
v_xor_b32 v20, 0xa5a, v16
v_xor_b32 v19, s59, v20
v_pk_add_f32 v[28:29], v[28:29], v[32:33]
v_pk_add_f32 v[30:31], v[30:31], v[34:35]
s_waitcnt lgkmcnt(5)
v_pk_add_f32 v[28:29], v[28:29], v[36:37]
v_pk_add_f32 v[30:31], v[30:31], v[38:39]
s_waitcnt lgkmcnt(4)
v_pk_add_f32 v[28:29], v[28:29], v[40:41]
v_pk_add_f32 v[30:31], v[30:31], v[42:43]
s_waitcnt lgkmcnt(3)
v_pk_add_f32 v[28:29], v[28:29], v[44:45]
v_pk_add_f32 v[30:31], v[30:31], v[46:47]
s_waitcnt lgkmcnt(2)
v_pk_add_f32 v[28:29], v[28:29], v[48:49]
v_pk_add_f32 v[30:31], v[30:31], v[50:51]
s_waitcnt lgkmcnt(1)
v_pk_add_f32 v[28:29], v[28:29], v[52:53]
v_pk_add_f32 v[30:31], v[30:31], v[54:55]
s_waitcnt lgkmcnt(0)
v_pk_add_f32 v[28:29], v[28:29], v[56:57]
v_pk_add_f32 v[30:31], v[30:31], v[58:59]
v_add_u32 v28, 0x800, v28
v_add_u32 v29, 0x800, v29
v_add_u32 v30, 0x800, v30
v_add_u32 v31, 0x800, v31
v_bfi_b32 v24, s63, v16, v28
v_bfi_b32 v25, s63, v17, v29
v_bfi_b32 v26, s63, v18, v30
v_bfi_b32 v27, s63, v19, v31
buffer_store_dwordx4 v[24:27], v7, s[32:35], s58 offen
buffer_load_dwordx4 v[144:147], v7, s[32:35], s58 offen sc1
s_add_u32 m0, s70, 3072
s_nop 0
buffer_load_dwordx4 v88, s[16:19], s56 offen offset:1024 nt lds
s_add_u32 m0, s70, 3840
s_nop 0
buffer_load_dwordx4 v89, s[16:19], s56 offen offset:1280 nt lds
s_add_u32 m0, s70, 4608
s_nop 0
buffer_load_dwordx4 v90, s[16:19], s56 offen offset:1536 nt lds
s_add_u32 m0, s70, 5376
s_nop 0
buffer_load_dwordx4 v91, s[16:19], s56 offen offset:1792 nt lds
v_and_b32 v28, 0xfffff000, v28
v_and_b32 v29, 0xfffff000, v29
v_and_b32 v30, 0xfffff000, v30
v_and_b32 v31, 0xfffff000, v31
s_barrier
buffer_load_dwordx4 v[32:35], v7, s[32:35], s5 offen nt
buffer_load_dwordx4 v[36:39], v7, s[32:35], s6 offen nt
buffer_load_dwordx4 v[40:43], v7, s[32:35], s7 offen nt
buffer_load_dwordx4 v[44:47], v7, s[32:35], s8 offen nt
buffer_load_dwordx4 v[48:51], v7, s[32:35], s9 offen nt
buffer_load_dwordx4 v[52:55], v7, s[32:35], s10 offen nt
buffer_load_dwordx4 v[56:59], v7, s[32:35], s11 offen nt
s_mov_b32 s68, 0
s_waitcnt vmcnt(7)
ds_read_b128 v[64:67], v172 offset:0
ds_read_b128 v[68:71], v173 offset:0
ds_read_b128 v[72:75], v174 offset:0
ds_read_b128 v[76:79], v175 offset:0
ds_read_b128 v[80:83], v172 offset:4096
ds_read_b128 v[84:87], v173 offset:4096
ds_read_b128 v[88:91], v174 offset:4096
ds_read_b128 v[92:95], v175 offset:4096
s_waitcnt vmcnt(6)
v_xor_b32 v32, v32, v16
v_xor_b32 v33, v33, v17
v_xor_b32 v34, v34, v18
v_xor_b32 v35, v35, v19
v_or3_b32 v60, v32, v33, v34
v_or_b32 v60, v60, v35
s_waitcnt vmcnt(5)
v_xor_b32 v36, v36, v16
v_xor_b32 v37, v37, v17
v_xor_b32 v38, v38, v18
v_xor_b32 v39, v39, v19
v_or3_b32 v60, v60, v36, v37
v_or3_b32 v60, v60, v38, v39
s_waitcnt vmcnt(4)
v_xor_b32 v40, v40, v16
v_xor_b32 v41, v41, v17
v_xor_b32 v42, v42, v18
v_xor_b32 v43, v43, v19
v_or3_b32 v60, v60, v40, v41
v_or3_b32 v60, v60, v42, v43
s_waitcnt vmcnt(3)
v_xor_b32 v44, v44, v16
v_xor_b32 v45, v45, v17
v_xor_b32 v46, v46, v18
v_xor_b32 v47, v47, v19
v_or3_b32 v60, v60, v44, v45
v_or3_b32 v60, v60, v46, v47
s_waitcnt vmcnt(2)
v_xor_b32 v48, v48, v16
v_xor_b32 v49, v49, v17
v_xor_b32 v50, v50, v18
v_xor_b32 v51, v51, v19
v_or3_b32 v60, v60, v48, v49
v_or3_b32 v60, v60, v50, v51
s_waitcnt vmcnt(1)
v_xor_b32 v52, v52, v16
v_xor_b32 v53, v53, v17
v_xor_b32 v54, v54, v18
v_xor_b32 v55, v55, v19
v_or3_b32 v60, v60, v52, v53
v_or3_b32 v60, v60, v54, v55
s_waitcnt vmcnt(0)
v_xor_b32 v56, v56, v16
v_xor_b32 v57, v57, v17
v_xor_b32 v58, v58, v18
v_xor_b32 v59, v59, v19
v_or3_b32 v60, v60, v56, v57
v_or3_b32 v60, v60, v58, v59
v_and_b32 v60, 0xfff, v60
v_cmp_ne_u32 vcc, 0, v60
s_nop 0
s_cbranch_vccz L_got
L_retry:
s_mov_b64 s[66:67], 0
v_or3_b32 v60, v32, v33, v34
v_or_b32 v60, v60, v35
v_and_b32 v60, 0xfff, v60
v_cmp_ne_u32 s[12:13], 0, v60
s_nop 0
s_or_b64 s[66:67], s[66:67], s[12:13]
v_or3_b32 v60, v36, v37, v38
v_or_b32 v60, v60, v39
v_and_b32 v60, 0xfff, v60
v_cmp_ne_u32 s[14:15], 0, v60
s_nop 0
s_or_b64 s[66:67], s[66:67], s[14:15]
v_or3_b32 v60, v40, v41, v42
v_or_b32 v60, v60, v43
v_and_b32 v60, 0xfff, v60
v_cmp_ne_u32 s[40:41], 0, v60
s_nop 0
s_or_b64 s[66:67], s[66:67], s[40:41]
v_or3_b32 v60, v44, v45, v46
v_or_b32 v60, v60, v47
v_and_b32 v60, 0xfff, v60
v_cmp_ne_u32 s[42:43], 0, v60
s_nop 0
s_or_b64 s[66:67], s[66:67], s[42:43]
v_or3_b32 v60, v48, v49, v50
v_or_b32 v60, v60, v51
v_and_b32 v60, 0xfff, v60
v_cmp_ne_u32 s[44:45], 0, v60
s_nop 0
s_or_b64 s[66:67], s[66:67], s[44:45]
v_or3_b32 v60, v52, v53, v54
v_or_b32 v60, v60, v55
v_and_b32 v60, 0xfff, v60
v_cmp_ne_u32 s[46:47], 0, v60
s_nop 0
s_or_b64 s[66:67], s[66:67], s[46:47]
v_or3_b32 v60, v56, v57, v58
v_or_b32 v60, v60, v59
v_and_b32 v60, 0xfff, v60
v_cmp_ne_u32 s[64:65], 0, v60
s_nop 0
s_or_b64 s[66:67], s[66:67], s[64:65]
s_cbranch_scc0 L_got
s_add_u32 s68, s68, 1
s_cmp_lg_u32 s68, 3
s_cbranch_scc1 L_nob
v_xor_b32 v27, s59, v27
s_add_u32 s60, s58, 2097152
buffer_store_dwordx4 v[24:27], v7, s[32:35], s60 offen sc1
L_nob:
s_and_b32 s60, s68, 3
s_cmp_eq_u32 s60, 3
s_cselect_b32 s69, 2097152, 0
s_cselect_b32 s60, 0, s59
v_xor_b32 v19, s60, v20
s_cmp_eq_u64 s[12:13], 0
s_cbranch_scc1 L_a1
s_add_u32 s60, s5, s69
buffer_load_dwordx4 v[32:35], v7, s[32:35], s60 offen sc1
L_a1:
s_cmp_eq_u64 s[14:15], 0
s_cbranch_scc1 L_a2
s_add_u32 s60, s6, s69
buffer_load_dwordx4 v[36:39], v7, s[32:35], s60 offen sc1
L_a2:
s_cmp_eq_u64 s[40:41], 0
s_cbranch_scc1 L_a3
s_add_u32 s60, s7, s69
buffer_load_dwordx4 v[40:43], v7, s[32:35], s60 offen sc1
L_a3:
s_cmp_eq_u64 s[42:43], 0
s_cbranch_scc1 L_a4
s_add_u32 s60, s8, s69
buffer_load_dwordx4 v[44:47], v7, s[32:35], s60 offen sc1
L_a4:
s_cmp_eq_u64 s[44:45], 0
s_cbranch_scc1 L_a5
s_add_u32 s60, s9, s69
buffer_load_dwordx4 v[48:51], v7, s[32:35], s60 offen sc1
L_a5:
s_cmp_eq_u64 s[46:47], 0
s_cbranch_scc1 L_a6
s_add_u32 s60, s10, s69
buffer_load_dwordx4 v[52:55], v7, s[32:35], s60 offen sc1
L_a6:
s_cmp_eq_u64 s[64:65], 0
s_cbranch_scc1 L_a7
s_add_u32 s60, s11, s69
buffer_load_dwordx4 v[56:59], v7, s[32:35], s60 offen sc1
L_a7:
s_waitcnt vmcnt(0)
s_cmp_eq_u64 s[12:13], 0
s_cbranch_scc1 L_b1
v_xor_b32 v32, v32, v16
v_xor_b32 v33, v33, v17
v_xor_b32 v34, v34, v18
v_xor_b32 v35, v35, v19
L_b1:
s_cmp_eq_u64 s[14:15], 0
s_cbranch_scc1 L_b2
v_xor_b32 v36, v36, v16
v_xor_b32 v37, v37, v17
v_xor_b32 v38, v38, v18
v_xor_b32 v39, v39, v19
L_b2:
s_cmp_eq_u64 s[40:41], 0
s_cbranch_scc1 L_b3
v_xor_b32 v40, v40, v16
v_xor_b32 v41, v41, v17
v_xor_b32 v42, v42, v18
v_xor_b32 v43, v43, v19
L_b3:
s_cmp_eq_u64 s[42:43], 0
s_cbranch_scc1 L_b4
v_xor_b32 v44, v44, v16
v_xor_b32 v45, v45, v17
v_xor_b32 v46, v46, v18
v_xor_b32 v47, v47, v19
L_b4:
s_cmp_eq_u64 s[44:45], 0
s_cbranch_scc1 L_b5
v_xor_b32 v48, v48, v16
v_xor_b32 v49, v49, v17
v_xor_b32 v50, v50, v18
v_xor_b32 v51, v51, v19
L_b5:
s_cmp_eq_u64 s[46:47], 0
s_cbranch_scc1 L_b6
v_xor_b32 v52, v52, v16
v_xor_b32 v53, v53, v17
v_xor_b32 v54, v54, v18
v_xor_b32 v55, v55, v19
L_b6:
s_cmp_eq_u64 s[64:65], 0
s_cbranch_scc1 L_b7
v_xor_b32 v56, v56, v16
v_xor_b32 v57, v57, v17
v_xor_b32 v58, v58, v18
v_xor_b32 v59, v59, v19
L_b7:
s_branch L_retry
L_got:
v_pk_add_f32 v[28:29], v[28:29], v[36:37]
v_pk_add_f32 v[44:45], v[44:45], v[52:53]
v_pk_add_f32 v[30:31], v[30:31], v[38:39]
v_pk_add_f32 v[46:47], v[46:47], v[54:55]
v_pk_add_f32 v[32:33], v[32:33], v[40:41]
v_pk_add_f32 v[48:49], v[48:49], v[56:57]
v_pk_add_f32 v[34:35], v[34:35], v[42:43]
v_pk_add_f32 v[50:51], v[50:51], v[58:59]
v_pk_add_f32 v[28:29], v[28:29], v[44:45]
v_pk_add_f32 v[30:31], v[30:31], v[46:47]
v_pk_add_f32 v[32:33], v[32:33], v[48:49]
v_pk_add_f32 v[34:35], v[34:35], v[50:51]
s_bitcmp1_b32 s49, 0
s_cbranch_scc1 L_isv
v_cvt_pk_bf16_f32 v38, v28, v29
v_cvt_pk_bf16_f32 v39, v30, v31
v_cvt_pk_bf16_f32 v36, v32, v33
v_cvt_pk_bf16_f32 v37, v34, v35
s_branch L_cv
L_isv:
v_cvt_pk_bf16_f32 v38, v32, v33
v_cvt_pk_bf16_f32 v39, v34, v35
v_cvt_pk_bf16_f32 v36, v28, v29
v_cvt_pk_bf16_f32 v37, v30, v31
L_cv:
ds_write_b16 v164, v38 offset:0
ds_write_b16_d16_hi v165, v38 offset:256
ds_write_b16 v166, v39 offset:512
ds_write_b16_d16_hi v167, v39 offset:768
ds_write_b64 v163, v[36:37]
s_waitcnt lgkmcnt(0)
s_barrier
ds_read_b128 v[24:27], v168
ds_read_b128 v[28:31], v169
ds_read_b128 v[32:35], v170
ds_read_b128 v[36:39], v171
ds_read_b128 v[40:43], v176 offset:0
ds_read_b128 v[44:47], v176 offset:1024
ds_read_b128 v[48:51], v176 offset:2048
ds_read_b128 v[52:55], v176 offset:3072
s_waitcnt lgkmcnt(7)
v_mfma_f32_16x16x32_bf16 v[56:59], v[24:27], v[64:67], 0
v_mfma_f32_16x16x32_bf16 v[60:63], v[24:27], v[80:83], 0
s_waitcnt lgkmcnt(6)
v_mfma_f32_16x16x32_bf16 v[56:59], v[28:31], v[68:71], v[56:59]
v_mfma_f32_16x16x32_bf16 v[60:63], v[28:31], v[84:87], v[60:63]
s_waitcnt lgkmcnt(5)
v_mfma_f32_16x16x32_bf16 v[56:59], v[32:35], v[72:75], v[56:59]
v_mfma_f32_16x16x32_bf16 v[60:63], v[32:35], v[88:91], v[60:63]
s_waitcnt lgkmcnt(4)
v_mfma_f32_16x16x32_bf16 v[56:59], v[36:39], v[76:79], v[56:59]
v_mfma_f32_16x16x32_bf16 v[60:63], v[36:39], v[92:95], v[60:63]
s_nop 6
v_max3_f32 v12, v56, v57, v58
v_max3_f32 v16, v60, v61, v62
v_max_f32 v12, v12, v59
v_max_f32 v16, v16, v63
s_nop 1
v_permlane32_swap_b32 v12, v16
s_nop 0
v_max_f32 v12, v12, v16
v_mov_b32 v16, v12
s_nop 1
v_permlane16_swap_b32 v12, v16
s_nop 0
v_max_f32 v12, v12, v16
v_mul_f32 v12, s71, v12
v_mov_b32 v16, v12
s_nop 1
v_permlane32_swap_b32 v12, v16
s_nop 0
v_pk_fma_f32 v[56:57], v[56:57], v[210:211], v[12:13] op_sel_hi:[1,1,0] neg_lo:[0,0,1] neg_hi:[0,0,1]
v_pk_fma_f32 v[60:61], v[60:61], v[210:211], v[16:17] op_sel_hi:[1,1,0] neg_lo:[0,0,1] neg_hi:[0,0,1]
v_pk_fma_f32 v[58:59], v[58:59], v[210:211], v[12:13] op_sel_hi:[1,1,0] neg_lo:[0,0,1] neg_hi:[0,0,1]
v_pk_fma_f32 v[62:63], v[62:63], v[210:211], v[16:17] op_sel_hi:[1,1,0] neg_lo:[0,0,1] neg_hi:[0,0,1]
v_exp_f32 v56, v56
v_exp_f32 v57, v57
v_exp_f32 v58, v58
v_exp_f32 v59, v59
v_exp_f32 v60, v60
v_exp_f32 v61, v61
v_exp_f32 v62, v62
v_exp_f32 v63, v63
s_nop 0
v_pk_add_f32 v[12:13], v[56:57], v[58:59]
v_pk_add_f32 v[16:17], v[60:61], v[62:63]
v_add_f32 v12, v12, v13
v_add_f32 v16, v16, v17
s_nop 1
v_permlane32_swap_b32 v12, v16
s_nop 0
v_add_f32 v12, v12, v16
v_mov_b32 v16, v12
s_nop 1
v_permlane16_swap_b32 v12, v16
s_nop 0
v_add_f32 v12, v12, v16
v_rcp_f32 v12, v12
s_nop 0
v_mov_b32 v16, v12
s_nop 1
v_permlane32_swap_b32 v12, v16
s_nop 0
v_pk_mul_f32 v[56:57], v[56:57], v[12:13] op_sel_hi:[1,0]
v_pk_mul_f32 v[58:59], v[58:59], v[12:13] op_sel_hi:[1,0]
v_pk_mul_f32 v[60:61], v[60:61], v[16:17] op_sel_hi:[1,0]
v_pk_mul_f32 v[62:63], v[62:63], v[16:17] op_sel_hi:[1,0]
v_cvt_pk_bf16_f32 v14, v56, v57
v_cvt_pk_bf16_f32 v15, v58, v59
v_cvt_pk_bf16_f32 v18, v60, v61
v_cvt_pk_bf16_f32 v19, v62, v63
s_waitcnt lgkmcnt(0)
v_mfma_f32_16x16x16_bf16 v[96:99], v[14:15], v[40:41], 0
v_mfma_f32_16x16x16_bf16 v[100:103], v[14:15], v[42:43], 0
v_mfma_f32_16x16x16_bf16 v[104:107], v[14:15], v[44:45], 0
v_mfma_f32_16x16x16_bf16 v[108:111], v[14:15], v[46:47], 0
v_mfma_f32_16x16x16_bf16 v[112:115], v[14:15], v[48:49], 0
v_mfma_f32_16x16x16_bf16 v[116:119], v[14:15], v[50:51], 0
v_mfma_f32_16x16x16_bf16 v[120:123], v[14:15], v[52:53], 0
v_mfma_f32_16x16x16_bf16 v[124:127], v[14:15], v[54:55], 0
v_mfma_f32_16x16x16_bf16 v[178:181], v[18:19], v[40:41], 0
v_mfma_f32_16x16x16_bf16 v[182:185], v[18:19], v[42:43], 0
v_cvt_pk_bf16_f32 v128, v96, v100
v_cvt_pk_bf16_f32 v132, v97, v101
v_cvt_pk_bf16_f32 v129, v104, v108
v_mfma_f32_16x16x16_bf16 v[186:189], v[18:19], v[44:45], 0
v_cvt_pk_bf16_f32 v133, v105, v109
v_cvt_pk_bf16_f32 v130, v112, v116
v_mfma_f32_16x16x16_bf16 v[190:193], v[18:19], v[46:47], 0
v_cvt_pk_bf16_f32 v134, v113, v117
v_cvt_pk_bf16_f32 v131, v120, v124
buffer_store_dwordx4 v[128:131], v5, s[28:31], s56 offen offset:0 nt
v_mfma_f32_16x16x16_bf16 v[194:197], v[18:19], v[48:49], 0
v_cvt_pk_bf16_f32 v135, v121, v125
buffer_store_dwordx4 v[132:135], v5, s[28:31], s56 offen offset:256 nt
v_cvt_pk_bf16_f32 v136, v98, v102
v_mfma_f32_16x16x16_bf16 v[198:201], v[18:19], v[50:51], 0
v_cvt_pk_bf16_f32 v137, v106, v110
v_cvt_pk_bf16_f32 v138, v114, v118
v_mfma_f32_16x16x16_bf16 v[202:205], v[18:19], v[52:53], 0
v_cvt_pk_bf16_f32 v139, v122, v126
buffer_store_dwordx4 v[136:139], v5, s[28:31], s56 offen offset:512 nt
v_mfma_f32_16x16x16_bf16 v[206:209], v[18:19], v[54:55], 0
v_cvt_pk_bf16_f32 v140, v99, v103
v_cvt_pk_bf16_f32 v141, v107, v111
v_cvt_pk_bf16_f32 v142, v115, v119
v_cvt_pk_bf16_f32 v143, v123, v127
buffer_store_dwordx4 v[140:143], v5, s[28:31], s56 offen offset:768 nt
v_cvt_pk_bf16_f32 v144, v178, v182
v_cvt_pk_bf16_f32 v145, v186, v190
v_cvt_pk_bf16_f32 v146, v194, v198
v_cvt_pk_bf16_f32 v147, v202, v206
buffer_store_dwordx4 v[144:147], v5, s[28:31], s56 offen offset:1024 nt
v_cvt_pk_bf16_f32 v148, v179, v183
v_cvt_pk_bf16_f32 v149, v187, v191
v_cvt_pk_bf16_f32 v150, v195, v199
v_cvt_pk_bf16_f32 v151, v203, v207
buffer_store_dwordx4 v[148:151], v5, s[28:31], s56 offen offset:1280 nt
v_cvt_pk_bf16_f32 v152, v180, v184
v_cvt_pk_bf16_f32 v153, v188, v192
v_cvt_pk_bf16_f32 v154, v196, v200
v_cvt_pk_bf16_f32 v155, v204, v208
buffer_store_dwordx4 v[152:155], v5, s[28:31], s56 offen offset:1536 nt
v_cvt_pk_bf16_f32 v156, v181, v185
v_cvt_pk_bf16_f32 v157, v189, v193
v_cvt_pk_bf16_f32 v158, v197, v201
v_cvt_pk_bf16_f32 v159, v205, v209
buffer_store_dwordx4 v[156:159], v5, s[28:31], s56 offen offset:1792 nt
L_end:
s_endpgm
.section .rodata,"a"
.p2align 6
.amdhsa_kernel standalone__low_rank_proj_linformer__prompt_kernel
  .amdhsa_next_free_vgpr 212
  .amdhsa_next_free_sgpr 96
  .amdhsa_accum_offset 212
  .amdhsa_group_segment_fixed_size 0
  .amdhsa_kernarg_size 64
  .amdhsa_user_sgpr_count 2
  .amdhsa_user_sgpr_kernarg_segment_ptr 1
  .amdhsa_system_sgpr_workgroup_id_x 1
.end_amdhsa_kernel
```
